```python
import torch

def _softmax(x, axis=-1):
    return torch.softmax(x, dim=axis)
def _gelu(x):
    return torch.nn.functional.gelu(x, approximate="tanh")
def _silu(x):
    return torch.nn.functional.silu(x)
def _sigmoid(x):
    return torch.sigmoid(x)
def _layernorm(x, axis=-1, eps=1e-5):
    m = x.mean(dim=axis, keepdim=True)
    v = x.var(dim=axis, keepdim=True, unbiased=False)
    return (x - m) / torch.sqrt(v + eps)
def _scatter_add(tgt, idx, src, axis=0):
    return tgt.clone().index_add_(axis, idx, src)
def _segment_sum(src, seg, n):
    out = torch.zeros((n,) + src.shape[1:], dtype=src.dtype)
    return out.index_add_(0, seg, src)
def _pad(x, pw):
    flat = tuple(v for pair in reversed(pw) for v in pair)
    return torch.nn.functional.pad(x, flat)

kernel_name = 'standalone__kv_cache_quant_int4_int2_kv_with_per_channel_or_per_token_scales__decode'

def setup_inputs():

    _w = (lambda a: (lambda t: t.to(torch.bfloat16) if t.is_floating_point() else t)(torch.as_tensor(a)))
    B = 1
    Sq = 1
    Skv = 32768
    Hq = 32
    Hkv = 8
    Dh = 128
    bits = 4
    G = -1
    if G <= 0 or G >= Skv:
        G = max(1, Skv // 2)
    Skv = (Skv // G) * G
    ngk = Skv // G
    qmax = (1 << bits) - 1
    return {
        "q": _w((lambda *s: torch.randn(*s, dtype=torch.bfloat16) * 1.6)(B, Hq, Sq, Dh)),
        "qk": _w(torch.randint(0, qmax + 1, (B, Hkv, Skv, Dh)).to(torch.int32)),
        "qv": _w(torch.randint(0, qmax + 1, (B, Hkv, Skv, Dh)).to(torch.int32)),
        "k_scales": _w(torch.abs((lambda *s: torch.randn(*s, dtype=torch.bfloat16) * 1.6)(B, Hkv, ngk, Dh)) * 0.05 + 0.02),
        "k_zeros": _w((lambda *s: torch.randn(*s, dtype=torch.bfloat16) * 1.6)(B, Hkv, ngk, Dh) + float(qmax) / 2.0),
        "v_scales": _w(torch.abs((lambda *s: torch.randn(*s, dtype=torch.bfloat16) * 0.05)(B, Hkv, Skv, 1)) * 0.05 + 0.02),
        "v_zeros": _w((lambda *s: torch.randn(*s, dtype=torch.bfloat16) * 0.05)(B, Hkv, Skv, 1) + float(qmax) / 2.0),
    }

def reference(q, qk, qv, k_scales, k_zeros, v_scales, v_zeros):
    B, Hq, Sq, Dh = q.shape
    Hkv, Skv = qk.shape[1], qk.shape[2]
    ngk = k_scales.shape[2]
    G = Skv // ngk
    ks = (lambda x, n, axis: torch.repeat_interleave(x, n, dim=axis))(k_scales, G, axis=2)
    kz = (lambda x, n, axis: torch.repeat_interleave(x, n, dim=axis))(k_zeros, G, axis=2)
    k = ((lambda x, dt: x.to(dt))(qk, q.dtype) - kz) * ks
    v = ((lambda x, dt: x.to(dt))(qv, q.dtype) - v_zeros) * v_scales
    rep = Hq // Hkv
    if rep > 1:
        k = (lambda x, n, axis: torch.repeat_interleave(x, n, dim=axis))(k, rep, axis=1)
        v = (lambda x, n, axis: torch.repeat_interleave(x, n, dim=axis))(v, rep, axis=1)
    scale = float(Dh) ** -0.5
    logits = torch.einsum("bhqd,bhkd->bhqk", q, k) * scale
    p = _softmax(logits, axis=-1)
    o = torch.einsum("bhqk,bhkd->bhqd", p, v)
    return o
```

```asm
; @launch grid=(256,1,1) block=(256,1,1) lds=107008
.amdgcn_target "amdgcn-amd-amdhsa--gfx950"
.text
.globl standalone__kv_cache_quant_int4_int2_kv_with_per_channel_or_per_token_scales__decode_kernel
.p2align 8
.type standalone__kv_cache_quant_int4_int2_kv_with_per_channel_or_per_token_scales__decode_kernel,@function
standalone__kv_cache_quant_int4_int2_kv_with_per_channel_or_per_token_scales__decode_kernel:
    s_cmp_ge_u32 s2, 256
    s_cbranch_scc1 L_end
    s_load_dwordx16 s[4:19], s[0:1], 0
    s_load_dwordx4 s[20:23], s[0:1], 64
    v_and_b32 v1, 63, v0
    v_lshrrev_b32 v5, 6, v0
    v_lshrrev_b32 v6, 4, v1
    v_and_b32 v7, 15, v1
    v_and_b32 v8, 3, v1
    v_readfirstlane_b32 s67, v5
    v_lshlrev_b32 v2, 13, v5
    v_lshrrev_b32 v12, 2, v7
    v_lshl_add_u32 v2, v12, 11, v2
    v_bfe_u32 v12, v7, 1, 1
    v_lshl_add_u32 v2, v12, 9, v2
    v_and_b32 v19, 1, v7
    v_lshl_add_u32 v2, v19, 6, v2
    v_lshl_add_u32 v2, v6, 4, v2
    v_lshlrev_b32 v12, 2, v0
    v_lshlrev_b32 v13, 2, v1
    s_bfe_u32 s64, s2, 0x20001
    s_lshr_b32 s78, s2, 6
    s_lshl_b32 s64, s64, 2
    s_add_u32 s64, s64, s78
    s_bfe_u32 s65, s2, 0x30003
    s_lshr_b32 s66, s64, 1
    s_lshl_b32 s70, s64, 23
    s_mul_i32 s77, s66, 16
    s_add_u32 s77, s77, s65
    s_and_b32 s79, s64, 1
    s_mul_i32 s78, s79, 64
    s_add_u32 s77, s77, s78
    s_lshl_b32 s79, s79, 4
    s_add_u32 s65, s65, s79
    s_and_b32 s79, s2, 1
    s_mov_b32 s76, 255
    s_mul_i32 s72, s79, 136
    s_lshl_b32 s79, s79, 3
    s_add_u32 s65, s65, s79
    s_mov_b32 s75, 0
    s_lshl_b32 s78, s75, 3
    s_add_u32 s78, s78, s77
    s_cmp_lt_u32 s75, 15
    s_cselect_b32 s79, s72, 0
    s_add_u32 s78, s78, s79
    s_and_b32 s78, s78, 255
    s_lshl_b32 s73, s78, 15
    s_add_u32 s73, s73, s70
    s_add_u32 s75, s75, 1
    s_lshl_b32 s82, s66, 10
    s_lshl_b32 s83, s64, 8
    s_mov_b32 s26, 0x8000000
    s_mov_b32 s27, 0x00020000
    s_mov_b32 s42, 0x2000
    s_mov_b32 s43, 0x00020000
    s_mov_b32 s46, 0x1000
    s_mov_b32 s47, 0x00020000
    s_mov_b32 s50, 0x1000
    s_mov_b32 s51, 0x00020000
    s_waitcnt lgkmcnt(0)
    s_mov_b32 s24, s6
    s_mov_b32 s25, s7
    buffer_load_dwordx4 v[108:111], v2, s[24:27], s73 offen offset:0 nt
    buffer_load_dwordx4 v[112:115], v2, s[24:27], s73 offen offset:128 nt
    buffer_load_dwordx4 v[116:119], v2, s[24:27], s73 offen offset:256 nt
    buffer_load_dwordx4 v[120:123], v2, s[24:27], s73 offen offset:384 nt
    buffer_load_dwordx4 v[124:127], v2, s[24:27], s73 offen offset:1024 nt
    buffer_load_dwordx4 v[128:131], v2, s[24:27], s73 offen offset:1152 nt
    buffer_load_dwordx4 v[132:135], v2, s[24:27], s73 offen offset:1280 nt
    buffer_load_dwordx4 v[136:139], v2, s[24:27], s73 offen offset:1408 nt
    s_mov_b32 s40, s4
    s_mov_b32 s41, s5
    s_mov_b32 s44, s10
    s_mov_b32 s45, s11
    s_mov_b32 s48, s12
    s_mov_b32 s49, s13
    buffer_load_dword v14, v12, s[40:43], s82 offen
    buffer_load_dword v15, v13, s[44:47], s83 offen
    buffer_load_dword v16, v13, s[48:51], s83 offen
    s_lshl_b32 s78, s75, 3
    s_add_u32 s78, s78, s77
    s_cmp_lt_u32 s75, 15
    s_cselect_b32 s79, s72, 0
    s_add_u32 s78, s78, s79
    s_and_b32 s78, s78, 255
    s_lshl_b32 s73, s78, 15
    s_add_u32 s73, s73, s70
    s_add_u32 s75, s75, 1
    buffer_load_dwordx4 v[140:143], v2, s[24:27], s73 offen offset:0 nt
    buffer_load_dwordx4 v[144:147], v2, s[24:27], s73 offen offset:128 nt
    buffer_load_dwordx4 v[148:151], v2, s[24:27], s73 offen offset:256 nt
    buffer_load_dwordx4 v[152:155], v2, s[24:27], s73 offen offset:384 nt
    buffer_load_dwordx4 v[156:159], v2, s[24:27], s73 offen offset:1024 nt
    buffer_load_dwordx4 v[160:163], v2, s[24:27], s73 offen offset:1152 nt
    buffer_load_dwordx4 v[164:167], v2, s[24:27], s73 offen offset:1280 nt
    buffer_load_dwordx4 v[168:171], v2, s[24:27], s73 offen offset:1408 nt
    s_mov_b32 s30, 0x8000000
    s_mov_b32 s31, 0x00020000
    s_mov_b32 s34, 0x80000
    s_mov_b32 s35, 0x00020000
    s_mov_b32 s38, 0x80000
    s_mov_b32 s39, 0x00020000
    s_mov_b32 s54, 0x2000
    s_mov_b32 s55, 0x00020000
    s_mov_b32 s58, 0x20000000
    s_mov_b32 s59, 0x00020000
    s_mov_b32 s62, 0x100
    s_mov_b32 s63, 0x00020000
    s_mov_b32 s28, s8
    s_mov_b32 s29, s9
    s_mov_b32 s32, s14
    s_mov_b32 s33, s15
    s_mov_b32 s36, s16
    s_mov_b32 s37, s17
    s_mov_b32 s52, s18
    s_mov_b32 s53, s19
    s_mov_b32 s56, s22
    s_mov_b32 s57, s23
    s_mov_b32 s60, s20
    s_mov_b32 s61, s21
    s_mov_b32 s68, 0x3e0293ee
    s_mov_b32 s69, 0xffff0000
    s_lshl_b32 s71, s64, 15
    v_lshlrev_b32 v3, 13, v5
    v_lshl_add_u32 v3, v6, 11, v3
    v_lshl_add_u32 v3, v7, 4, v3
    s_getreg_b32 s74, hwreg(HW_REG_XCC_ID)
    s_xor_b32 s74, s74, s2
    s_and_b32 s74, s74, 1
    s_add_u32 s74, s74, 1
    v_mov_b32 v46, 0
    v_mov_b32 v44, s74
    v_mov_b32 v45, 0
    s_or_b32 s78, s2, s67
    s_cbranch_scc1 L_nowr
    s_mov_b64 exec, 1
    buffer_atomic_cmpswap v[44:45], v46, s[60:63], 0 offen offset:4
    s_mov_b64 exec, -1
L_nowr:
    v_lshrrev_b32 v17, 1, v1
    v_cmp_gt_u32 vcc, 15, v17
    v_mov_b32 v18, s72
    v_lshlrev_b32 v17, 3, v17
    v_add_u32 v17, s77, v17
    v_cndmask_b32 v18, 0, v18, vcc
    v_add_u32 v17, v17, v18
    v_and_b32 v17, 255, v17
    v_lshlrev_b32 v4, 7, v17
    v_lshl_add_u32 v4, v5, 5, v4
    v_lshl_add_u32 v4, v19, 4, v4
    v_and_b32 v17, 8, v1
    v_cmp_ne_u32 s[80:81], 0, v17
    v_and_b32 v18, 4, v1
    v_mov_b32 v10, 0xff7fffff
    v_mov_b32 v11, 0
    v_mov_b32 v72, 0
    v_mov_b32 v73, 0
    v_mov_b32 v74, 0
    v_mov_b32 v75, 0
    v_mov_b32 v76, 0
    v_mov_b32 v77, 0
    v_mov_b32 v78, 0
    v_mov_b32 v79, 0
    v_mov_b32 v80, 0
    v_mov_b32 v81, 0
    v_mov_b32 v82, 0
    v_mov_b32 v83, 0
    v_mov_b32 v84, 0
    v_mov_b32 v85, 0
    v_mov_b32 v86, 0
    v_mov_b32 v87, 0
    v_mov_b32 v88, 0
    v_mov_b32 v89, 0
    v_mov_b32 v90, 0
    v_mov_b32 v91, 0
    v_mov_b32 v92, 0
    v_mov_b32 v93, 0
    v_mov_b32 v94, 0
    v_mov_b32 v95, 0
    v_mov_b32 v96, 0
    v_mov_b32 v97, 0
    v_mov_b32 v98, 0
    v_mov_b32 v99, 0
    v_mov_b32 v100, 0
    v_mov_b32 v101, 0
    v_mov_b32 v102, 0
    v_mov_b32 v103, 0
    v_mov_b32 v104, 0
    v_mov_b32 v105, 0
    v_mov_b32 v106, 0
    v_mov_b32 v107, 0
    v_mul_u32_u24 v9, 17408, v5
    v_lshl_add_u32 v9, v1, 4, v9
    v_lshlrev_b32 v17, 7, v17
    v_lshl_add_u32 v17, v8, 8, v17
    v_lshl_add_u32 v17, v18, 3, v17
    v_lshl_add_u32 v17, v6, 3, v17
    v_lshlrev_b32 v19, 5, v19
    v_lshl_add_u32 v19, v6, 3, v19
    s_mov_b32 s78, 0x07060302
    s_waitcnt vmcnt(8)
    v_lshlrev_b32 v32, 16, v14
    v_and_b32 v33, s69, v14
    v_lshlrev_b32 v34, 16, v15
    v_and_b32 v35, s69, v15
    v_mul_f32 v32, v32, v34
    v_mul_f32 v33, v33, v35
    v_and_b32 v34, s69, v32
    v_and_b32 v35, s69, v33
    v_sub_f32 v34, v32, v34
    v_sub_f32 v35, v33, v35
    v_perm_b32 v32, v33, v32, s78
    v_perm_b32 v34, v35, v34, s78
    ds_write_b32 v12, v32 offset:0
    ds_write_b32 v12, v34 offset:1024
    ds_write_b32 v13, v16 offset:2048
    s_waitcnt lgkmcnt(0)
    s_barrier
    ds_read_b64 v[20:21], v17 offset:0
    ds_read_b64 v[22:23], v17 offset:64
    ds_read_b64 v[24:25], v17 offset:128
    ds_read_b64 v[26:27], v17 offset:192
    ds_read_b64 v[56:57], v19 offset:2048
    ds_read_b64 v[58:59], v19 offset:2112
    ds_read_b64 v[60:61], v19 offset:2176
    ds_read_b64 v[62:63], v19 offset:2240
    s_waitcnt lgkmcnt(0)
    v_mfma_f32_16x16x32_bf16 v[28:31], v[56:59], v[20:23], 0
    v_mfma_f32_16x16x32_bf16 v[28:31], v[60:63], v[24:27], v[28:31]
    s_nop 9
    v_xor_b32 v28, 0x80000000, v28
    v_xor_b32 v29, 0x80000000, v29
    v_xor_b32 v30, 0x80000000, v30
    v_xor_b32 v31, 0x80000000, v31
L_k:
    s_lshl_b32 s78, s75, 3
    s_add_u32 s78, s78, s77
    s_cmp_lt_u32 s75, 15
    s_cselect_b32 s79, s72, 0
    s_add_u32 s78, s78, s79
    s_and_b32 s78, s78, 255
    s_lshl_b32 s73, s78, 15
    s_add_u32 s73, s73, s70
    s_add_u32 s75, s75, 1
    s_waitcnt vmcnt(15)
    v_cvt_f32_i32 v108, v108
    v_cvt_f32_i32 v109, v109
    v_cvt_f32_i32 v110, v110
    v_cvt_f32_i32 v111, v111
    s_waitcnt vmcnt(14)
    v_cvt_f32_i32 v112, v112
    v_cvt_f32_i32 v113, v113
    v_cvt_f32_i32 v114, v114
    v_cvt_f32_i32 v115, v115
    v_cvt_pk_bf16_f32 v56, v108, v109
    v_cvt_pk_bf16_f32 v57, v110, v111
    v_cvt_pk_bf16_f32 v58, v112, v113
    v_cvt_pk_bf16_f32 v59, v114, v115
    buffer_load_dwordx4 v[108:111], v2, s[24:27], s73 offen offset:0 nt
    buffer_load_dwordx4 v[112:115], v2, s[24:27], s73 offen offset:128 nt
    v_mfma_f32_16x16x32_bf16 v[32:35], v[56:59], v[20:23], v[28:31]
    s_waitcnt vmcnt(15)
    v_cvt_f32_i32 v116, v116
    v_cvt_f32_i32 v117, v117
    v_cvt_f32_i32 v118, v118
    v_cvt_f32_i32 v119, v119
    s_waitcnt vmcnt(14)
    v_cvt_f32_i32 v120, v120
    v_cvt_f32_i32 v121, v121
    v_cvt_f32_i32 v122, v122
    v_cvt_f32_i32 v123, v123
    v_cvt_pk_bf16_f32 v60, v116, v117
    v_cvt_pk_bf16_f32 v61, v118, v119
    v_cvt_pk_bf16_f32 v62, v120, v121
    v_cvt_pk_bf16_f32 v63, v122, v123
    buffer_load_dwordx4 v[116:119], v2, s[24:27], s73 offen offset:256 nt
    buffer_load_dwordx4 v[120:123], v2, s[24:27], s73 offen offset:384 nt
    v_mfma_f32_16x16x32_bf16 v[32:35], v[60:63], v[24:27], v[32:35]
    s_waitcnt vmcnt(15)
    v_cvt_f32_i32 v124, v124
    v_cvt_f32_i32 v125, v125
    v_cvt_f32_i32 v126, v126
    v_cvt_f32_i32 v127, v127
    s_waitcnt vmcnt(14)
    v_cvt_f32_i32 v128, v128
    v_cvt_f32_i32 v129, v129
    v_cvt_f32_i32 v130, v130
    v_cvt_f32_i32 v131, v131
    v_cvt_pk_bf16_f32 v56, v124, v125
    v_cvt_pk_bf16_f32 v57, v126, v127
    v_cvt_pk_bf16_f32 v58, v128, v129
    v_cvt_pk_bf16_f32 v59, v130, v131
    buffer_load_dwordx4 v[124:127], v2, s[24:27], s73 offen offset:1024 nt
    buffer_load_dwordx4 v[128:131], v2, s[24:27], s73 offen offset:1152 nt
    v_mfma_f32_16x16x32_bf16 v[36:39], v[56:59], v[20:23], v[28:31]
    s_waitcnt vmcnt(15)
    v_cvt_f32_i32 v132, v132
    v_cvt_f32_i32 v133, v133
    v_cvt_f32_i32 v134, v134
    v_cvt_f32_i32 v135, v135
    s_waitcnt vmcnt(14)
    v_cvt_f32_i32 v136, v136
    v_cvt_f32_i32 v137, v137
    v_cvt_f32_i32 v138, v138
    v_cvt_f32_i32 v139, v139
    v_cvt_pk_bf16_f32 v60, v132, v133
    v_cvt_pk_bf16_f32 v61, v134, v135
    v_cvt_pk_bf16_f32 v62, v136, v137
    v_cvt_pk_bf16_f32 v63, v138, v139
    buffer_load_dwordx4 v[132:135], v2, s[24:27], s73 offen offset:1280 nt
    buffer_load_dwordx4 v[136:139], v2, s[24:27], s73 offen offset:1408 nt
    v_mfma_f32_16x16x32_bf16 v[36:39], v[60:63], v[24:27], v[36:39]
    v_add_f32_dpp v40, v33, v32 row_ror:4 row_mask:0xf bank_mask:0xf
    v_add_f32_dpp v41, v35, v34 row_ror:4 row_mask:0xf bank_mask:0xf
    s_nop 0
    v_add_f32_dpp v40, v40, v40 row_ror:8 row_mask:0xf bank_mask:0xf
    v_add_f32_dpp v41, v41, v41 row_ror:8 row_mask:0xf bank_mask:0xf
    v_max3_f32 v10, v10, v40, v41
    s_nop 2
    v_add_f32_dpp v42, v37, v36 row_ror:4 row_mask:0xf bank_mask:0xf
    v_add_f32_dpp v43, v39, v38 row_ror:4 row_mask:0xf bank_mask:0xf
    s_nop 0
    v_add_f32_dpp v42, v42, v42 row_ror:8 row_mask:0xf bank_mask:0xf
    v_add_f32_dpp v43, v43, v43 row_ror:8 row_mask:0xf bank_mask:0xf
    ds_write_b128 v9, v[40:43] offset:37376
    v_max3_f32 v10, v10, v42, v43
    v_add_u32 v9, 1024, v9
    s_cmp_ge_u32 s75, s76
    s_cbranch_scc1 L_kt
    s_cmp_lg_u32 s75, 7
    s_cbranch_scc1 L_nold
    buffer_load_dword v47, v46, s[60:63], 0 offen offset:4 sc1
L_nold:
    s_cmp_lg_u32 s75, 11
    s_cbranch_scc1 L_nores
    v_readfirstlane_b32 s78, v47
    s_nop 0
    s_cmp_lg_u32 s78, 0
    s_cbranch_scc1 L_have
    s_mov_b64 exec, 1
    buffer_atomic_cmpswap v[44:45], v46, s[60:63], 0 offen offset:4 sc0
    s_waitcnt vmcnt(0)
    v_readfirstlane_b32 s78, v44
    s_mov_b64 exec, -1
    s_cmp_eq_u32 s78, 0
    s_cselect_b32 s78, s74, s78
L_have:
    s_xor_b32 s78, s78, s2
    s_and_b32 s78, s78, 1
    s_cselect_b32 s76, 17, 15
L_nores:
    s_lshl_b32 s78, s75, 3
    s_add_u32 s78, s78, s77
    s_cmp_lt_u32 s75, 15
    s_cselect_b32 s79, s72, 0
    s_add_u32 s78, s78, s79
    s_and_b32 s78, s78, 255
    s_lshl_b32 s73, s78, 15
    s_add_u32 s73, s73, s70
    s_add_u32 s75, s75, 1
    s_waitcnt vmcnt(15)
    v_cvt_f32_i32 v140, v140
    v_cvt_f32_i32 v141, v141
    v_cvt_f32_i32 v142, v142
    v_cvt_f32_i32 v143, v143
    s_waitcnt vmcnt(14)
    v_cvt_f32_i32 v144, v144
    v_cvt_f32_i32 v145, v145
    v_cvt_f32_i32 v146, v146
    v_cvt_f32_i32 v147, v147
    v_cvt_pk_bf16_f32 v56, v140, v141
    v_cvt_pk_bf16_f32 v57, v142, v143
    v_cvt_pk_bf16_f32 v58, v144, v145
    v_cvt_pk_bf16_f32 v59, v146, v147
    buffer_load_dwordx4 v[140:143], v2, s[24:27], s73 offen offset:0 nt
    buffer_load_dwordx4 v[144:147], v2, s[24:27], s73 offen offset:128 nt
    v_mfma_f32_16x16x32_bf16 v[32:35], v[56:59], v[20:23], v[28:31]
    s_waitcnt vmcnt(15)
    v_cvt_f32_i32 v148, v148
    v_cvt_f32_i32 v149, v149
    v_cvt_f32_i32 v150, v150
    v_cvt_f32_i32 v151, v151
    s_waitcnt vmcnt(14)
    v_cvt_f32_i32 v152, v152
    v_cvt_f32_i32 v153, v153
    v_cvt_f32_i32 v154, v154
    v_cvt_f32_i32 v155, v155
    v_cvt_pk_bf16_f32 v60, v148, v149
    v_cvt_pk_bf16_f32 v61, v150, v151
    v_cvt_pk_bf16_f32 v62, v152, v153
    v_cvt_pk_bf16_f32 v63, v154, v155
    buffer_load_dwordx4 v[148:151], v2, s[24:27], s73 offen offset:256 nt
    buffer_load_dwordx4 v[152:155], v2, s[24:27], s73 offen offset:384 nt
    v_mfma_f32_16x16x32_bf16 v[32:35], v[60:63], v[24:27], v[32:35]
    s_waitcnt vmcnt(15)
    v_cvt_f32_i32 v156, v156
    v_cvt_f32_i32 v157, v157
    v_cvt_f32_i32 v158, v158
    v_cvt_f32_i32 v159, v159
    s_waitcnt vmcnt(14)
    v_cvt_f32_i32 v160, v160
    v_cvt_f32_i32 v161, v161
    v_cvt_f32_i32 v162, v162
    v_cvt_f32_i32 v163, v163
    v_cvt_pk_bf16_f32 v56, v156, v157
    v_cvt_pk_bf16_f32 v57, v158, v159
    v_cvt_pk_bf16_f32 v58, v160, v161
    v_cvt_pk_bf16_f32 v59, v162, v163
    buffer_load_dwordx4 v[156:159], v2, s[24:27], s73 offen offset:1024 nt
    buffer_load_dwordx4 v[160:163], v2, s[24:27], s73 offen offset:1152 nt
    v_mfma_f32_16x16x32_bf16 v[36:39], v[56:59], v[20:23], v[28:31]
    s_waitcnt vmcnt(15)
    v_cvt_f32_i32 v164, v164
    v_cvt_f32_i32 v165, v165
    v_cvt_f32_i32 v166, v166
    v_cvt_f32_i32 v167, v167
    s_waitcnt vmcnt(14)
    v_cvt_f32_i32 v168, v168
    v_cvt_f32_i32 v169, v169
    v_cvt_f32_i32 v170, v170
    v_cvt_f32_i32 v171, v171
    v_cvt_pk_bf16_f32 v60, v164, v165
    v_cvt_pk_bf16_f32 v61, v166, v167
    v_cvt_pk_bf16_f32 v62, v168, v169
    v_cvt_pk_bf16_f32 v63, v170, v171
    buffer_load_dwordx4 v[164:167], v2, s[24:27], s73 offen offset:1280 nt
    buffer_load_dwordx4 v[168:171], v2, s[24:27], s73 offen offset:1408 nt
    v_mfma_f32_16x16x32_bf16 v[36:39], v[60:63], v[24:27], v[36:39]
    v_add_f32_dpp v40, v33, v32 row_ror:4 row_mask:0xf bank_mask:0xf
    v_add_f32_dpp v41, v35, v34 row_ror:4 row_mask:0xf bank_mask:0xf
    s_nop 0
    v_add_f32_dpp v40, v40, v40 row_ror:8 row_mask:0xf bank_mask:0xf
    v_add_f32_dpp v41, v41, v41 row_ror:8 row_mask:0xf bank_mask:0xf
    v_max3_f32 v10, v10, v40, v41
    s_nop 2
    v_add_f32_dpp v42, v37, v36 row_ror:4 row_mask:0xf bank_mask:0xf
    v_add_f32_dpp v43, v39, v38 row_ror:4 row_mask:0xf bank_mask:0xf
    s_nop 0
    v_add_f32_dpp v42, v42, v42 row_ror:8 row_mask:0xf bank_mask:0xf
    v_add_f32_dpp v43, v43, v43 row_ror:8 row_mask:0xf bank_mask:0xf
    ds_write_b128 v9, v[40:43] offset:37376
    v_max3_f32 v10, v10, v42, v43
    v_add_u32 v9, 1024, v9
    s_branch L_k
L_kt:
    s_mov_b32 s75, 0
    s_lshl_b32 s78, s76, 1
    v_cmp_gt_u32 vcc, s78, v1
    s_nop 0
    s_mov_b64 exec, vcc
    buffer_load_dwordx4 v[48:51], v4, s[32:35], s71 offen nt
    buffer_load_dwordx4 v[52:55], v4, s[36:39], s71 offen nt
    s_mov_b64 exec, -1
    s_lshl_b32 s78, s75, 3
    s_add_u32 s78, s78, s77
    s_cmp_lt_u32 s75, 15
    s_cselect_b32 s79, s72, 0
    s_add_u32 s78, s78, s79
    s_and_b32 s78, s78, 255
    s_lshl_b32 s73, s78, 15
    s_add_u32 s73, s73, s70
    s_add_u32 s75, s75, 1
    s_waitcnt vmcnt(17)
    v_cvt_f32_i32 v140, v140
    v_cvt_f32_i32 v141, v141
    v_cvt_f32_i32 v142, v142
    v_cvt_f32_i32 v143, v143
    s_waitcnt vmcnt(16)
    v_cvt_f32_i32 v144, v144
    v_cvt_f32_i32 v145, v145
    v_cvt_f32_i32 v146, v146
    v_cvt_f32_i32 v147, v147
    v_cvt_pk_bf16_f32 v56, v140, v141
    v_cvt_pk_bf16_f32 v57, v142, v143
    v_cvt_pk_bf16_f32 v58, v144, v145
    v_cvt_pk_bf16_f32 v59, v146, v147
    buffer_load_dwordx4 v[140:143], v3, s[28:31], s73 offen offset:0 nt
    buffer_load_dwordx4 v[144:147], v3, s[28:31], s73 offen offset:512 nt
    v_mfma_f32_16x16x32_bf16 v[32:35], v[56:59], v[20:23], v[28:31]
    s_waitcnt vmcnt(17)
    v_cvt_f32_i32 v148, v148
    v_cvt_f32_i32 v149, v149
    v_cvt_f32_i32 v150, v150
    v_cvt_f32_i32 v151, v151
    s_waitcnt vmcnt(16)
    v_cvt_f32_i32 v152, v152
    v_cvt_f32_i32 v153, v153
    v_cvt_f32_i32 v154, v154
    v_cvt_f32_i32 v155, v155
    v_cvt_pk_bf16_f32 v60, v148, v149
    v_cvt_pk_bf16_f32 v61, v150, v151
    v_cvt_pk_bf16_f32 v62, v152, v153
    v_cvt_pk_bf16_f32 v63, v154, v155
    buffer_load_dwordx4 v[148:151], v3, s[28:31], s73 offen offset:1024 nt
    buffer_load_dwordx4 v[152:155], v3, s[28:31], s73 offen offset:1536 nt
    v_mfma_f32_16x16x32_bf16 v[32:35], v[60:63], v[24:27], v[32:35]
    s_waitcnt vmcnt(17)
    v_cvt_f32_i32 v156, v156
    v_cvt_f32_i32 v157, v157
    v_cvt_f32_i32 v158, v158
    v_cvt_f32_i32 v159, v159
    s_waitcnt vmcnt(16)
    v_cvt_f32_i32 v160, v160
    v_cvt_f32_i32 v161, v161
    v_cvt_f32_i32 v162, v162
    v_cvt_f32_i32 v163, v163
    v_cvt_pk_bf16_f32 v56, v156, v157
    v_cvt_pk_bf16_f32 v57, v158, v159
    v_cvt_pk_bf16_f32 v58, v160, v161
    v_cvt_pk_bf16_f32 v59, v162, v163
    buffer_load_dwordx4 v[156:159], v3, s[28:31], s73 offen offset:256 nt
    buffer_load_dwordx4 v[160:163], v3, s[28:31], s73 offen offset:768 nt
    v_mfma_f32_16x16x32_bf16 v[36:39], v[56:59], v[20:23], v[28:31]
    s_waitcnt vmcnt(17)
    v_cvt_f32_i32 v164, v164
    v_cvt_f32_i32 v165, v165
    v_cvt_f32_i32 v166, v166
    v_cvt_f32_i32 v167, v167
    s_waitcnt vmcnt(16)
    v_cvt_f32_i32 v168, v168
    v_cvt_f32_i32 v169, v169
    v_cvt_f32_i32 v170, v170
    v_cvt_f32_i32 v171, v171
    v_cvt_pk_bf16_f32 v60, v164, v165
    v_cvt_pk_bf16_f32 v61, v166, v167
    v_cvt_pk_bf16_f32 v62, v168, v169
    v_cvt_pk_bf16_f32 v63, v170, v171
    buffer_load_dwordx4 v[164:167], v3, s[28:31], s73 offen offset:1280 nt
    buffer_load_dwordx4 v[168:171], v3, s[28:31], s73 offen offset:1792 nt
    v_mfma_f32_16x16x32_bf16 v[36:39], v[60:63], v[24:27], v[36:39]
    v_add_f32_dpp v40, v33, v32 row_ror:4 row_mask:0xf bank_mask:0xf
    v_add_f32_dpp v41, v35, v34 row_ror:4 row_mask:0xf bank_mask:0xf
    s_nop 0
    v_add_f32_dpp v40, v40, v40 row_ror:8 row_mask:0xf bank_mask:0xf
    v_add_f32_dpp v41, v41, v41 row_ror:8 row_mask:0xf bank_mask:0xf
    v_max3_f32 v10, v10, v40, v41
    s_nop 2
    v_add_f32_dpp v42, v37, v36 row_ror:4 row_mask:0xf bank_mask:0xf
    v_add_f32_dpp v43, v39, v38 row_ror:4 row_mask:0xf bank_mask:0xf
    s_nop 0
    v_add_f32_dpp v42, v42, v42 row_ror:8 row_mask:0xf bank_mask:0xf
    v_add_f32_dpp v43, v43, v43 row_ror:8 row_mask:0xf bank_mask:0xf
    ds_write_b128 v9, v[40:43] offset:37376
    v_max3_f32 v10, v10, v42, v43
    v_add_u32 v9, 1024, v9
    s_lshl_b32 s78, s75, 3
    s_add_u32 s78, s78, s77
    s_cmp_lt_u32 s75, 15
    s_cselect_b32 s79, s72, 0
    s_add_u32 s78, s78, s79
    s_and_b32 s78, s78, 255
    s_lshl_b32 s73, s78, 15
    s_add_u32 s73, s73, s70
    s_add_u32 s75, s75, 1
    s_waitcnt vmcnt(17)
    v_cvt_f32_i32 v108, v108
    v_cvt_f32_i32 v109, v109
    v_cvt_f32_i32 v110, v110
    v_cvt_f32_i32 v111, v111
    s_waitcnt vmcnt(16)
    v_cvt_f32_i32 v112, v112
    v_cvt_f32_i32 v113, v113
    v_cvt_f32_i32 v114, v114
    v_cvt_f32_i32 v115, v115
    v_cvt_pk_bf16_f32 v56, v108, v109
    v_cvt_pk_bf16_f32 v57, v110, v111
    v_cvt_pk_bf16_f32 v58, v112, v113
    v_cvt_pk_bf16_f32 v59, v114, v115
    buffer_load_dwordx4 v[108:111], v3, s[28:31], s73 offen offset:0 nt
    buffer_load_dwordx4 v[112:115], v3, s[28:31], s73 offen offset:512 nt
    v_mfma_f32_16x16x32_bf16 v[32:35], v[56:59], v[20:23], v[28:31]
    s_waitcnt vmcnt(17)
    v_cvt_f32_i32 v116, v116
    v_cvt_f32_i32 v117, v117
    v_cvt_f32_i32 v118, v118
    v_cvt_f32_i32 v119, v119
    s_waitcnt vmcnt(16)
    v_cvt_f32_i32 v120, v120
    v_cvt_f32_i32 v121, v121
    v_cvt_f32_i32 v122, v122
    v_cvt_f32_i32 v123, v123
    v_cvt_pk_bf16_f32 v60, v116, v117
    v_cvt_pk_bf16_f32 v61, v118, v119
    v_cvt_pk_bf16_f32 v62, v120, v121
    v_cvt_pk_bf16_f32 v63, v122, v123
    buffer_load_dwordx4 v[116:119], v3, s[28:31], s73 offen offset:1024 nt
    buffer_load_dwordx4 v[120:123], v3, s[28:31], s73 offen offset:1536 nt
    v_mfma_f32_16x16x32_bf16 v[32:35], v[60:63], v[24:27], v[32:35]
    s_waitcnt vmcnt(17)
    v_cvt_f32_i32 v124, v124
    v_cvt_f32_i32 v125, v125
    v_cvt_f32_i32 v126, v126
    v_cvt_f32_i32 v127, v127
    s_waitcnt vmcnt(16)
    v_cvt_f32_i32 v128, v128
    v_cvt_f32_i32 v129, v129
    v_cvt_f32_i32 v130, v130
    v_cvt_f32_i32 v131, v131
    v_cvt_pk_bf16_f32 v56, v124, v125
    v_cvt_pk_bf16_f32 v57, v126, v127
    v_cvt_pk_bf16_f32 v58, v128, v129
    v_cvt_pk_bf16_f32 v59, v130, v131
    buffer_load_dwordx4 v[124:127], v3, s[28:31], s73 offen offset:256 nt
    buffer_load_dwordx4 v[128:131], v3, s[28:31], s73 offen offset:768 nt
    v_mfma_f32_16x16x32_bf16 v[36:39], v[56:59], v[20:23], v[28:31]
    s_waitcnt vmcnt(17)
    v_cvt_f32_i32 v132, v132
    v_cvt_f32_i32 v133, v133
    v_cvt_f32_i32 v134, v134
    v_cvt_f32_i32 v135, v135
    s_waitcnt vmcnt(16)
    v_cvt_f32_i32 v136, v136
    v_cvt_f32_i32 v137, v137
    v_cvt_f32_i32 v138, v138
    v_cvt_f32_i32 v139, v139
    v_cvt_pk_bf16_f32 v60, v132, v133
    v_cvt_pk_bf16_f32 v61, v134, v135
    v_cvt_pk_bf16_f32 v62, v136, v137
    v_cvt_pk_bf16_f32 v63, v138, v139
    buffer_load_dwordx4 v[132:135], v3, s[28:31], s73 offen offset:1280 nt
    buffer_load_dwordx4 v[136:139], v3, s[28:31], s73 offen offset:1792 nt
    v_mfma_f32_16x16x32_bf16 v[36:39], v[60:63], v[24:27], v[36:39]
    v_add_f32_dpp v40, v33, v32 row_ror:4 row_mask:0xf bank_mask:0xf
    v_add_f32_dpp v41, v35, v34 row_ror:4 row_mask:0xf bank_mask:0xf
    s_nop 0
    v_add_f32_dpp v40, v40, v40 row_ror:8 row_mask:0xf bank_mask:0xf
    v_add_f32_dpp v41, v41, v41 row_ror:8 row_mask:0xf bank_mask:0xf
    v_max3_f32 v10, v10, v40, v41
    s_nop 2
    v_add_f32_dpp v42, v37, v36 row_ror:4 row_mask:0xf bank_mask:0xf
    v_add_f32_dpp v43, v39, v38 row_ror:4 row_mask:0xf bank_mask:0xf
    s_nop 0
    v_add_f32_dpp v42, v42, v42 row_ror:8 row_mask:0xf bank_mask:0xf
    v_add_f32_dpp v43, v43, v43 row_ror:8 row_mask:0xf bank_mask:0xf
    ds_write_b128 v9, v[40:43] offset:37376
    v_max3_f32 v10, v10, v42, v43
    v_add_u32 v9, 1024, v9
    v_mov_b32 v13, v10
    v_lshlrev_b32 v14, 2, v5
    v_lshl_add_u32 v14, v8, 4, v14
    v_permlane16_swap_b32 v10, v13
    v_max_f32 v10, v10, v13
    v_mov_b32 v13, v10
    v_lshlrev_b32 v15, 4, v8
    v_mul_u32_u24 v9, 17408, v5
    v_permlane32_swap_b32 v10, v13
    v_max_f32 v10, v10, v13
    v_lshl_add_u32 v9, v1, 4, v9
    s_mov_b64 exec, 0xf
    ds_write_b32 v14, v10 offset:2304
    s_mov_b64 exec, -1
    v_lshrrev_b32 v16, 1, v1
    v_lshlrev_b32 v16, 8, v16
    v_and_b32 v17, 1, v1
    v_lshl_add_u32 v16, v17, 4, v16
    v_lshl_add_u32 v16, v5, 5, v16
    v_lshlrev_b32 v4, 5, v5
    v_lshl_add_u32 v4, v6, 3, v4
    v_add_u32 v4, 29184, v4
    s_waitcnt vmcnt(16)
    ds_write_b128 v16, v[48:51] offset:29184
    ds_write_b128 v16, v[52:55] offset:29312
    v_lshrrev_b32 v12, 5, v1
    v_mul_u32_u24 v20, 6144, v5
    v_mul_u32_u24 v13, 3072, v12
    v_add_u32 v20, v20, v13
    v_lshl_add_u32 v20, v7, 4, v20
    v_bfe_u32 v36, v1, 3, 2
    v_and_b32 v37, 7, v1
    v_lshrrev_b32 v38, 1, v5
    v_lshl_add_u32 v38, v38, 2, v36
    v_mul_u32_u24 v21, 384, v38
    v_add_u32 v21, v21, v13
    v_and_b32 v38, 1, v5
    v_lshl_add_u32 v21, v38, 7, v21
    v_lshl_add_u32 v21, v37, 4, v21
    v_lshrrev_b32 v38, 1, v8
    v_lshlrev_b32 v25, 4, v38
    v_and_b32 v38, 1, v8
    v_lshl_add_u32 v25, v38, 2, v25
    v_lshl_add_u32 v22, v5, 5, v25
    v_lshlrev_b32 v24, 4, v12
    v_and_b32 v38, 31, v1
    v_lshlrev_b32 v23, 4, v38
    v_lshl_add_u32 v23, v12, 3, v23
    v_lshlrev_b32 v26, 4, v1
    v_lshl_add_u32 v27, v5, 9, v23
    v_lshl_add_u32 v28, v5, 9, v24
    v_lshl_add_u32 v29, v37, 2, v36
    v_lshlrev_b32 v29, 1, v29
    v_lshl_add_u32 v29, v12, 9, v29
    v_lshl_add_u32 v31, v38, 5, v24
    v_mov_b32 v30, 0
    s_lshl_b32 s78, s66, 2
    s_add_u32 s78, s78, s67
    s_lshl_b32 s94, s78, 14
    s_lshl_b32 s96, s65, 9
    s_add_u32 s96, s96, s94
    s_lshl_b32 s95, s66, 10
    s_add_u32 s95, s95, 524288
    s_lshl_b32 s97, s65, 5
    s_add_u32 s97, s97, s95
    s_lshl_b32 s98, s66, 5
    s_lshl_b32 s78, s67, 6
    s_add_u32 s82, s82, s78
    s_waitcnt lgkmcnt(0)
    s_barrier
    ds_read_b128 v[32:35], v15 offset:2304
    s_waitcnt lgkmcnt(0)
    v_max3_f32 v10, v10, v32, v33
    v_max3_f32 v10, v10, v34, v35
    v_mul_f32 v10, s68, v10
    s_cmp_lg_u32 s67, 0
    s_cbranch_scc1 L_v
    s_mov_b64 exec, 0xf
    ds_write_b32 v25, v10 offset:2384
    s_mov_b64 exec, -1
L_v:
    ds_read_b128 v[40:43], v9 offset:37376
    ds_read2_b64 v[48:51], v4 offset0:0 offset1:16
    s_lshl_b32 s78, s75, 3
    s_add_u32 s78, s78, s77
    s_cmp_lt_u32 s75, 15
    s_cselect_b32 s79, s72, 0
    s_add_u32 s78, s78, s79
    s_and_b32 s78, s78, 255
    s_lshl_b32 s73, s78, 15
    s_add_u32 s73, s73, s70
    s_add_u32 s75, s75, 1
    v_add_u32 v9, 1024, v9
    v_add_u32 v4, 256, v4
    s_waitcnt lgkmcnt(0)
    v_fma_f32 v40, v40, s68, -v10
    v_fma_f32 v41, v41, s68, -v10
    v_fma_f32 v42, v42, s68, -v10
    v_fma_f32 v43, v43, s68, -v10
    v_exp_f32 v40, v40
    v_exp_f32 v41, v41
    v_exp_f32 v42, v42
    v_exp_f32 v43, v43
    v_lshlrev_b32 v16, 16, v48
    v_and_b32 v17, s69, v48
    v_lshlrev_b32 v18, 16, v49
    v_and_b32 v19, s69, v49
    v_add_f32 v12, v40, v41
    v_mul_f32 v16, v16, v40
    v_add_f32 v13, v42, v43
    v_mul_f32 v17, v17, v41
    v_mul_f32 v18, v18, v42
    v_mul_f32 v19, v19, v43
    v_add_f32 v11, v11, v12
    v_and_b32 v40, s69, v16
    v_and_b32 v41, s69, v17
    v_and_b32 v42, s69, v18
    v_and_b32 v43, s69, v19
    v_add_f32 v11, v11, v13
    v_sub_f32 v16, v16, v40
    v_sub_f32 v17, v17, v41
    v_sub_f32 v18, v18, v42
    v_sub_f32 v19, v19, v43
    v_cndmask_b32 v16, v40, v16, s[80:81]
    v_cndmask_b32 v17, v41, v17, s[80:81]
    v_cndmask_b32 v18, v42, v18, s[80:81]
    v_cndmask_b32 v19, v43, v19, s[80:81]
    v_cvt_pk_bf16_f32 v44, v16, v17
    v_cvt_pk_bf16_f32 v45, v18, v19
    s_nop 1
    v_mfma_f32_16x16x16_bf16 v[104:107], v[44:45], v[50:51], v[104:107]
    s_waitcnt vmcnt(15)
    v_cvt_f32_i32 v140, v140
    v_cvt_f32_i32 v141, v141
    v_cvt_f32_i32 v142, v142
    v_cvt_f32_i32 v143, v143
    s_waitcnt vmcnt(14)
    v_cvt_f32_i32 v144, v144
    v_cvt_f32_i32 v145, v145
    v_cvt_f32_i32 v146, v146
    v_cvt_f32_i32 v147, v147
    v_cvt_pk_bf16_f32 v56, v140, v144
    v_cvt_pk_bf16_f32 v58, v141, v145
    v_cvt_pk_bf16_f32 v60, v142, v146
    v_cvt_pk_bf16_f32 v62, v143, v147
    buffer_load_dwordx4 v[140:143], v3, s[28:31], s73 offen offset:0 nt
    buffer_load_dwordx4 v[144:147], v3, s[28:31], s73 offen offset:512 nt
    s_waitcnt vmcnt(15)
    v_cvt_f32_i32 v148, v148
    v_cvt_f32_i32 v149, v149
    v_cvt_f32_i32 v150, v150
    v_cvt_f32_i32 v151, v151
    s_waitcnt vmcnt(14)
    v_cvt_f32_i32 v152, v152
    v_cvt_f32_i32 v153, v153
    v_cvt_f32_i32 v154, v154
    v_cvt_f32_i32 v155, v155
    v_cvt_pk_bf16_f32 v57, v148, v152
    v_cvt_pk_bf16_f32 v59, v149, v153
    v_cvt_pk_bf16_f32 v61, v150, v154
    v_cvt_pk_bf16_f32 v63, v151, v155
    buffer_load_dwordx4 v[148:151], v3, s[28:31], s73 offen offset:1024 nt
    buffer_load_dwordx4 v[152:155], v3, s[28:31], s73 offen offset:1536 nt
    v_mfma_f32_16x16x16_bf16 v[72:75], v[44:45], v[56:57], v[72:75]
    v_mfma_f32_16x16x16_bf16 v[76:79], v[44:45], v[58:59], v[76:79]
    v_mfma_f32_16x16x16_bf16 v[80:83], v[44:45], v[60:61], v[80:83]
    v_mfma_f32_16x16x16_bf16 v[84:87], v[44:45], v[62:63], v[84:87]
    s_waitcnt vmcnt(15)
    v_cvt_f32_i32 v156, v156
    v_cvt_f32_i32 v157, v157
    v_cvt_f32_i32 v158, v158
    v_cvt_f32_i32 v159, v159
    s_waitcnt vmcnt(14)
    v_cvt_f32_i32 v160, v160
    v_cvt_f32_i32 v161, v161
    v_cvt_f32_i32 v162, v162
    v_cvt_f32_i32 v163, v163
    v_cvt_pk_bf16_f32 v64, v156, v160
    v_cvt_pk_bf16_f32 v66, v157, v161
    v_cvt_pk_bf16_f32 v68, v158, v162
    v_cvt_pk_bf16_f32 v70, v159, v163
    buffer_load_dwordx4 v[156:159], v3, s[28:31], s73 offen offset:256 nt
    buffer_load_dwordx4 v[160:163], v3, s[28:31], s73 offen offset:768 nt
    s_waitcnt vmcnt(15)
    v_cvt_f32_i32 v164, v164
    v_cvt_f32_i32 v165, v165
    v_cvt_f32_i32 v166, v166
    v_cvt_f32_i32 v167, v167
    s_waitcnt vmcnt(14)
    v_cvt_f32_i32 v168, v168
    v_cvt_f32_i32 v169, v169
    v_cvt_f32_i32 v170, v170
    v_cvt_f32_i32 v171, v171
    v_cvt_pk_bf16_f32 v65, v164, v168
    v_cvt_pk_bf16_f32 v67, v165, v169
    v_cvt_pk_bf16_f32 v69, v166, v170
    v_cvt_pk_bf16_f32 v71, v167, v171
    buffer_load_dwordx4 v[164:167], v3, s[28:31], s73 offen offset:1280 nt
    buffer_load_dwordx4 v[168:171], v3, s[28:31], s73 offen offset:1792 nt
    v_mfma_f32_16x16x16_bf16 v[88:91], v[44:45], v[64:65], v[88:91]
    v_mfma_f32_16x16x16_bf16 v[92:95], v[44:45], v[66:67], v[92:95]
    v_mfma_f32_16x16x16_bf16 v[96:99], v[44:45], v[68:69], v[96:99]
    v_mfma_f32_16x16x16_bf16 v[100:103], v[44:45], v[70:71], v[100:103]
    s_cmp_ge_u32 s75, s76
    s_cbranch_scc1 L_vt
    ds_read_b128 v[40:43], v9 offset:37376
    ds_read2_b64 v[48:51], v4 offset0:0 offset1:16
    s_lshl_b32 s78, s75, 3
    s_add_u32 s78, s78, s77
    s_cmp_lt_u32 s75, 15
    s_cselect_b32 s79, s72, 0
    s_add_u32 s78, s78, s79
    s_and_b32 s78, s78, 255
    s_lshl_b32 s73, s78, 15
    s_add_u32 s73, s73, s70
    s_add_u32 s75, s75, 1
    v_add_u32 v9, 1024, v9
    v_add_u32 v4, 256, v4
    s_waitcnt lgkmcnt(0)
    v_fma_f32 v40, v40, s68, -v10
    v_fma_f32 v41, v41, s68, -v10
    v_fma_f32 v42, v42, s68, -v10
    v_fma_f32 v43, v43, s68, -v10
    v_exp_f32 v40, v40
    v_exp_f32 v41, v41
    v_exp_f32 v42, v42
    v_exp_f32 v43, v43
    v_lshlrev_b32 v16, 16, v48
    v_and_b32 v17, s69, v48
    v_lshlrev_b32 v18, 16, v49
    v_and_b32 v19, s69, v49
    v_add_f32 v12, v40, v41
    v_mul_f32 v16, v16, v40
    v_add_f32 v13, v42, v43
    v_mul_f32 v17, v17, v41
    v_mul_f32 v18, v18, v42
    v_mul_f32 v19, v19, v43
    v_add_f32 v11, v11, v12
    v_and_b32 v40, s69, v16
    v_and_b32 v41, s69, v17
    v_and_b32 v42, s69, v18
    v_and_b32 v43, s69, v19
    v_add_f32 v11, v11, v13
    v_sub_f32 v16, v16, v40
    v_sub_f32 v17, v17, v41
    v_sub_f32 v18, v18, v42
    v_sub_f32 v19, v19, v43
    v_cndmask_b32 v16, v40, v16, s[80:81]
    v_cndmask_b32 v17, v41, v17, s[80:81]
    v_cndmask_b32 v18, v42, v18, s[80:81]
    v_cndmask_b32 v19, v43, v19, s[80:81]
    v_cvt_pk_bf16_f32 v44, v16, v17
    v_cvt_pk_bf16_f32 v45, v18, v19
    s_nop 1
    v_mfma_f32_16x16x16_bf16 v[104:107], v[44:45], v[50:51], v[104:107]
    s_waitcnt vmcnt(15)
    v_cvt_f32_i32 v108, v108
    v_cvt_f32_i32 v109, v109
    v_cvt_f32_i32 v110, v110
    v_cvt_f32_i32 v111, v111
    s_waitcnt vmcnt(14)
    v_cvt_f32_i32 v112, v112
    v_cvt_f32_i32 v113, v113
    v_cvt_f32_i32 v114, v114
    v_cvt_f32_i32 v115, v115
    v_cvt_pk_bf16_f32 v56, v108, v112
    v_cvt_pk_bf16_f32 v58, v109, v113
    v_cvt_pk_bf16_f32 v60, v110, v114
    v_cvt_pk_bf16_f32 v62, v111, v115
    buffer_load_dwordx4 v[108:111], v3, s[28:31], s73 offen offset:0 nt
    buffer_load_dwordx4 v[112:115], v3, s[28:31], s73 offen offset:512 nt
    s_waitcnt vmcnt(15)
    v_cvt_f32_i32 v116, v116
    v_cvt_f32_i32 v117, v117
    v_cvt_f32_i32 v118, v118
    v_cvt_f32_i32 v119, v119
    s_waitcnt vmcnt(14)
    v_cvt_f32_i32 v120, v120
    v_cvt_f32_i32 v121, v121
    v_cvt_f32_i32 v122, v122
    v_cvt_f32_i32 v123, v123
    v_cvt_pk_bf16_f32 v57, v116, v120
    v_cvt_pk_bf16_f32 v59, v117, v121
    v_cvt_pk_bf16_f32 v61, v118, v122
    v_cvt_pk_bf16_f32 v63, v119, v123
    buffer_load_dwordx4 v[116:119], v3, s[28:31], s73 offen offset:1024 nt
    buffer_load_dwordx4 v[120:123], v3, s[28:31], s73 offen offset:1536 nt
    v_mfma_f32_16x16x16_bf16 v[72:75], v[44:45], v[56:57], v[72:75]
    v_mfma_f32_16x16x16_bf16 v[76:79], v[44:45], v[58:59], v[76:79]
    v_mfma_f32_16x16x16_bf16 v[80:83], v[44:45], v[60:61], v[80:83]
    v_mfma_f32_16x16x16_bf16 v[84:87], v[44:45], v[62:63], v[84:87]
    s_waitcnt vmcnt(15)
    v_cvt_f32_i32 v124, v124
    v_cvt_f32_i32 v125, v125
    v_cvt_f32_i32 v126, v126
    v_cvt_f32_i32 v127, v127
    s_waitcnt vmcnt(14)
    v_cvt_f32_i32 v128, v128
    v_cvt_f32_i32 v129, v129
    v_cvt_f32_i32 v130, v130
    v_cvt_f32_i32 v131, v131
    v_cvt_pk_bf16_f32 v64, v124, v128
    v_cvt_pk_bf16_f32 v66, v125, v129
    v_cvt_pk_bf16_f32 v68, v126, v130
    v_cvt_pk_bf16_f32 v70, v127, v131
    buffer_load_dwordx4 v[124:127], v3, s[28:31], s73 offen offset:256 nt
    buffer_load_dwordx4 v[128:131], v3, s[28:31], s73 offen offset:768 nt
    s_waitcnt vmcnt(15)
    v_cvt_f32_i32 v132, v132
    v_cvt_f32_i32 v133, v133
    v_cvt_f32_i32 v134, v134
    v_cvt_f32_i32 v135, v135
    s_waitcnt vmcnt(14)
    v_cvt_f32_i32 v136, v136
    v_cvt_f32_i32 v137, v137
    v_cvt_f32_i32 v138, v138
    v_cvt_f32_i32 v139, v139
    v_cvt_pk_bf16_f32 v65, v132, v136
    v_cvt_pk_bf16_f32 v67, v133, v137
    v_cvt_pk_bf16_f32 v69, v134, v138
    v_cvt_pk_bf16_f32 v71, v135, v139
    buffer_load_dwordx4 v[132:135], v3, s[28:31], s73 offen offset:1280 nt
    buffer_load_dwordx4 v[136:139], v3, s[28:31], s73 offen offset:1792 nt
    v_mfma_f32_16x16x16_bf16 v[88:91], v[44:45], v[64:65], v[88:91]
    v_mfma_f32_16x16x16_bf16 v[92:95], v[44:45], v[66:67], v[92:95]
    v_mfma_f32_16x16x16_bf16 v[96:99], v[44:45], v[68:69], v[96:99]
    v_mfma_f32_16x16x16_bf16 v[100:103], v[44:45], v[70:71], v[100:103]
    s_branch L_v
L_vt:
    ds_read_b128 v[40:43], v9 offset:37376
    ds_read2_b64 v[48:51], v4 offset0:0 offset1:16
    v_add_u32 v9, 1024, v9
    v_add_u32 v4, 256, v4
    s_waitcnt lgkmcnt(0)
    v_fma_f32 v40, v40, s68, -v10
    v_fma_f32 v41, v41, s68, -v10
    v_fma_f32 v42, v42, s68, -v10
    v_fma_f32 v43, v43, s68, -v10
    v_exp_f32 v40, v40
    v_exp_f32 v41, v41
    v_exp_f32 v42, v42
    v_exp_f32 v43, v43
    v_lshlrev_b32 v16, 16, v48
    v_and_b32 v17, s69, v48
    v_lshlrev_b32 v18, 16, v49
    v_and_b32 v19, s69, v49
    v_add_f32 v12, v40, v41
    v_mul_f32 v16, v16, v40
    v_add_f32 v13, v42, v43
    v_mul_f32 v17, v17, v41
    v_mul_f32 v18, v18, v42
    v_mul_f32 v19, v19, v43
    v_add_f32 v11, v11, v12
    v_and_b32 v40, s69, v16
    v_and_b32 v41, s69, v17
    v_and_b32 v42, s69, v18
    v_and_b32 v43, s69, v19
    v_add_f32 v11, v11, v13
    v_sub_f32 v16, v16, v40
    v_sub_f32 v17, v17, v41
    v_sub_f32 v18, v18, v42
    v_sub_f32 v19, v19, v43
    v_cndmask_b32 v16, v40, v16, s[80:81]
    v_cndmask_b32 v17, v41, v17, s[80:81]
    v_cndmask_b32 v18, v42, v18, s[80:81]
    v_cndmask_b32 v19, v43, v19, s[80:81]
    v_cvt_pk_bf16_f32 v44, v16, v17
    v_cvt_pk_bf16_f32 v45, v18, v19
    s_nop 1
    v_mfma_f32_16x16x16_bf16 v[104:107], v[44:45], v[50:51], v[104:107]
    s_waitcnt vmcnt(15)
    v_cvt_f32_i32 v108, v108
    v_cvt_f32_i32 v109, v109
    v_cvt_f32_i32 v110, v110
    v_cvt_f32_i32 v111, v111
    s_waitcnt vmcnt(14)
    v_cvt_f32_i32 v112, v112
    v_cvt_f32_i32 v113, v113
    v_cvt_f32_i32 v114, v114
    v_cvt_f32_i32 v115, v115
    v_cvt_pk_bf16_f32 v56, v108, v112
    v_cvt_pk_bf16_f32 v58, v109, v113
    v_cvt_pk_bf16_f32 v60, v110, v114
    v_cvt_pk_bf16_f32 v62, v111, v115
    s_waitcnt vmcnt(13)
    v_cvt_f32_i32 v116, v116
    v_cvt_f32_i32 v117, v117
    v_cvt_f32_i32 v118, v118
    v_cvt_f32_i32 v119, v119
    s_waitcnt vmcnt(12)
    v_cvt_f32_i32 v120, v120
    v_cvt_f32_i32 v121, v121
    v_cvt_f32_i32 v122, v122
    v_cvt_f32_i32 v123, v123
    v_cvt_pk_bf16_f32 v57, v116, v120
    v_cvt_pk_bf16_f32 v59, v117, v121
    v_cvt_pk_bf16_f32 v61, v118, v122
    v_cvt_pk_bf16_f32 v63, v119, v123
    s_nop 0
    v_mfma_f32_16x16x16_bf16 v[72:75], v[44:45], v[56:57], v[72:75]
    v_mfma_f32_16x16x16_bf16 v[76:79], v[44:45], v[58:59], v[76:79]
    v_mfma_f32_16x16x16_bf16 v[80:83], v[44:45], v[60:61], v[80:83]
    v_mfma_f32_16x16x16_bf16 v[84:87], v[44:45], v[62:63], v[84:87]
    s_waitcnt vmcnt(11)
    v_cvt_f32_i32 v124, v124
    v_cvt_f32_i32 v125, v125
    v_cvt_f32_i32 v126, v126
    v_cvt_f32_i32 v127, v127
    s_waitcnt vmcnt(10)
    v_cvt_f32_i32 v128, v128
    v_cvt_f32_i32 v129, v129
    v_cvt_f32_i32 v130, v130
    v_cvt_f32_i32 v131, v131
    v_cvt_pk_bf16_f32 v64, v124, v128
    v_cvt_pk_bf16_f32 v66, v125, v129
    v_cvt_pk_bf16_f32 v68, v126, v130
    v_cvt_pk_bf16_f32 v70, v127, v131
    s_waitcnt vmcnt(9)
    v_cvt_f32_i32 v132, v132
    v_cvt_f32_i32 v133, v133
    v_cvt_f32_i32 v134, v134
    v_cvt_f32_i32 v135, v135
    s_waitcnt vmcnt(8)
    v_cvt_f32_i32 v136, v136
    v_cvt_f32_i32 v137, v137
    v_cvt_f32_i32 v138, v138
    v_cvt_f32_i32 v139, v139
    v_cvt_pk_bf16_f32 v65, v132, v136
    v_cvt_pk_bf16_f32 v67, v133, v137
    v_cvt_pk_bf16_f32 v69, v134, v138
    v_cvt_pk_bf16_f32 v71, v135, v139
    s_nop 0
    v_mfma_f32_16x16x16_bf16 v[88:91], v[44:45], v[64:65], v[88:91]
    v_mfma_f32_16x16x16_bf16 v[92:95], v[44:45], v[66:67], v[92:95]
    v_mfma_f32_16x16x16_bf16 v[96:99], v[44:45], v[68:69], v[96:99]
    v_mfma_f32_16x16x16_bf16 v[100:103], v[44:45], v[70:71], v[100:103]
    ds_read_b128 v[40:43], v9 offset:37376
    ds_read2_b64 v[48:51], v4 offset0:0 offset1:16
    v_add_u32 v9, 1024, v9
    v_add_u32 v4, 256, v4
    s_waitcnt lgkmcnt(0)
    v_fma_f32 v40, v40, s68, -v10
    v_fma_f32 v41, v41, s68, -v10
    v_fma_f32 v42, v42, s68, -v10
    v_fma_f32 v43, v43, s68, -v10
    v_exp_f32 v40, v40
    v_exp_f32 v41, v41
    v_exp_f32 v42, v42
    v_exp_f32 v43, v43
    v_lshlrev_b32 v16, 16, v48
    v_and_b32 v17, s69, v48
    v_lshlrev_b32 v18, 16, v49
    v_and_b32 v19, s69, v49
    v_add_f32 v12, v40, v41
    v_mul_f32 v16, v16, v40
    v_add_f32 v13, v42, v43
    v_mul_f32 v17, v17, v41
    v_mul_f32 v18, v18, v42
    v_mul_f32 v19, v19, v43
    v_add_f32 v11, v11, v12
    v_and_b32 v40, s69, v16
    v_and_b32 v41, s69, v17
    v_and_b32 v42, s69, v18
    v_and_b32 v43, s69, v19
    v_add_f32 v11, v11, v13
    v_sub_f32 v16, v16, v40
    v_sub_f32 v17, v17, v41
    v_sub_f32 v18, v18, v42
    v_sub_f32 v19, v19, v43
    v_cndmask_b32 v16, v40, v16, s[80:81]
    v_cndmask_b32 v17, v41, v17, s[80:81]
    v_cndmask_b32 v18, v42, v18, s[80:81]
    v_cndmask_b32 v19, v43, v19, s[80:81]
    v_cvt_pk_bf16_f32 v44, v16, v17
    v_cvt_pk_bf16_f32 v45, v18, v19
    s_nop 1
    v_mfma_f32_16x16x16_bf16 v[104:107], v[44:45], v[50:51], v[104:107]
    v_mov_b32 v13, v11
    s_nop 1
    v_permlane16_swap_b32 v11, v13
    v_add_f32 v11, v11, v13
    v_mov_b32 v13, v11
    s_nop 1
    v_permlane32_swap_b32 v11, v13
    v_add_f32 v11, v11, v13
    v_permlane32_swap_b32 v104, v106
    v_permlane32_swap_b32 v105, v107
    v_lshl_add_u32 v12, v5, 5, v24
    v_pk_add_f32 v[104:105], v[104:105], v[106:107]
    s_mov_b64 exec, 0xf
    ds_write_b32 v22, v11 offset:2432
    s_mov_b32 exec_lo, 1
    s_mov_b32 exec_hi, 1
    ds_write_b64 v12, v[104:105] offset:2440
    s_mov_b64 exec, -1
    ds_read_b64 v[32:33], v24 offset:2384
    s_waitcnt vmcnt(7)
    v_cvt_f32_i32 v140, v140
    v_cvt_f32_i32 v141, v141
    v_cvt_f32_i32 v142, v142
    v_cvt_f32_i32 v143, v143
    s_waitcnt vmcnt(6)
    v_cvt_f32_i32 v144, v144
    v_cvt_f32_i32 v145, v145
    v_cvt_f32_i32 v146, v146
    v_cvt_f32_i32 v147, v147
    v_cvt_pk_bf16_f32 v56, v140, v144
    v_cvt_pk_bf16_f32 v58, v141, v145
    v_cvt_pk_bf16_f32 v60, v142, v146
    v_cvt_pk_bf16_f32 v62, v143, v147
    s_waitcnt vmcnt(5)
    v_cvt_f32_i32 v148, v148
    v_cvt_f32_i32 v149, v149
    v_cvt_f32_i32 v150, v150
    v_cvt_f32_i32 v151, v151
    s_waitcnt vmcnt(4)
    v_cvt_f32_i32 v152, v152
    v_cvt_f32_i32 v153, v153
    v_cvt_f32_i32 v154, v154
    v_cvt_f32_i32 v155, v155
    v_cvt_pk_bf16_f32 v57, v148, v152
    v_cvt_pk_bf16_f32 v59, v149, v153
    v_cvt_pk_bf16_f32 v61, v150, v154
    v_cvt_pk_bf16_f32 v63, v151, v155
    s_nop 0
    v_mfma_f32_16x16x16_bf16 v[72:75], v[44:45], v[56:57], v[72:75]
    v_mfma_f32_16x16x16_bf16 v[76:79], v[44:45], v[58:59], v[76:79]
    v_mfma_f32_16x16x16_bf16 v[80:83], v[44:45], v[60:61], v[80:83]
    v_mfma_f32_16x16x16_bf16 v[84:87], v[44:45], v[62:63], v[84:87]
    s_waitcnt vmcnt(3)
    v_cvt_f32_i32 v156, v156
    v_cvt_f32_i32 v157, v157
    v_cvt_f32_i32 v158, v158
    v_cvt_f32_i32 v159, v159
    s_waitcnt vmcnt(2)
    v_cvt_f32_i32 v160, v160
    v_cvt_f32_i32 v161, v161
    v_cvt_f32_i32 v162, v162
    v_cvt_f32_i32 v163, v163
    v_cvt_pk_bf16_f32 v64, v156, v160
    v_cvt_pk_bf16_f32 v66, v157, v161
    v_cvt_pk_bf16_f32 v68, v158, v162
    v_cvt_pk_bf16_f32 v70, v159, v163
    s_mov_b32 exec_lo, 0xffff
    s_mov_b32 exec_hi, 0xffff
    ds_write_b128 v20, v[72:75] offset:4608
    ds_write_b128 v20, v[76:79] offset:4992
    ds_write_b128 v20, v[80:83] offset:5376
    ds_write_b128 v20, v[84:87] offset:5760
    s_mov_b64 exec, -1
    s_waitcnt vmcnt(1)
    v_cvt_f32_i32 v164, v164
    v_cvt_f32_i32 v165, v165
    v_cvt_f32_i32 v166, v166
    v_cvt_f32_i32 v167, v167
    s_waitcnt vmcnt(0)
    v_cvt_f32_i32 v168, v168
    v_cvt_f32_i32 v169, v169
    v_cvt_f32_i32 v170, v170
    v_cvt_f32_i32 v171, v171
    v_cvt_pk_bf16_f32 v65, v164, v168
    v_cvt_pk_bf16_f32 v67, v165, v169
    v_cvt_pk_bf16_f32 v69, v166, v170
    v_cvt_pk_bf16_f32 v71, v167, v171
    s_nop 0
    v_mfma_f32_16x16x16_bf16 v[88:91], v[44:45], v[64:65], v[88:91]
    v_mfma_f32_16x16x16_bf16 v[92:95], v[44:45], v[66:67], v[92:95]
    v_mfma_f32_16x16x16_bf16 v[96:99], v[44:45], v[68:69], v[96:99]
    v_mfma_f32_16x16x16_bf16 v[100:103], v[44:45], v[70:71], v[100:103]
    s_mov_b32 exec_lo, 0xffff
    s_mov_b32 exec_hi, 0xffff
    s_nop 3
    ds_write_b128 v20, v[88:91] offset:6144
    ds_write_b128 v20, v[92:95] offset:6528
    ds_write_b128 v20, v[96:99] offset:6912
    ds_write_b128 v20, v[100:103] offset:7296
    s_mov_b64 exec, -1
    s_waitcnt lgkmcnt(0)
    s_barrier
    ds_read_b128 v[108:111], v21 offset:4608
    ds_read_b128 v[112:115], v21 offset:10752
    ds_read_b128 v[116:119], v21 offset:16896
    ds_read_b128 v[120:123], v21 offset:23040
    ds_read_b128 v[124:127], v24 offset:2432
    ds_read_b128 v[128:131], v24 offset:2464
    ds_read_b128 v[132:135], v24 offset:2496
    ds_read_b128 v[136:139], v24 offset:2528
    s_waitcnt lgkmcnt(6)
    v_pk_add_f32 v[108:109], v[108:109], v[112:113]
    v_pk_add_f32 v[110:111], v[110:111], v[114:115]
    s_waitcnt lgkmcnt(4)
    v_pk_add_f32 v[116:117], v[116:117], v[120:121]
    v_pk_add_f32 v[118:119], v[118:119], v[122:123]
    v_pk_add_f32 v[108:109], v[108:109], v[116:117]
    v_pk_add_f32 v[110:111], v[110:111], v[118:119]
    s_waitcnt lgkmcnt(0)
    v_pk_add_f32 v[126:127], v[126:127], v[130:131]
    v_pk_add_f32 v[134:135], v[134:135], v[138:139]
    v_permlane32_swap_b32 v108, v110
    v_permlane32_swap_b32 v109, v111
    v_pk_add_f32 v[126:127], v[126:127], v[134:135]
    v_pk_add_f32 v[108:109], v[108:109], v[110:111]
    v_pk_add_f32 v[124:125], v[124:125], v[128:129]
    v_pk_add_f32 v[108:109], v[108:109], v[126:127] neg_lo:[0,1] neg_hi:[0,1]
    buffer_store_dwordx2 v[108:109], v23, s[56:59], s96 offen sc1
    s_cmp_lg_u32 s67, 0
    s_cbranch_scc1 L_noL
    v_pk_add_f32 v[132:133], v[132:133], v[136:137]
    s_mov_b32 exec_lo, 1
    s_mov_b32 exec_hi, 1
    v_pk_add_f32 v[34:35], v[124:125], v[132:133]
    buffer_store_dwordx4 v[32:35], v24, s[56:59], s97 offen sc1
    s_mov_b64 exec, 1
    v_mov_b32 v13, 1
L_noL:
    s_waitcnt vmcnt(0)
    s_barrier
    s_cmp_lg_u32 s67, 0
    s_cbranch_scc1 L_skip_atomic
    buffer_atomic_add v13, v30, s[60:63], s98 offen sc0
    s_waitcnt vmcnt(0)
    ds_write_b32 v30, v13 offset:2368
    s_mov_b64 exec, -1
    s_waitcnt lgkmcnt(0)
L_skip_atomic:
    s_barrier
    ds_read_b32 v13, v30 offset:2368
    s_waitcnt lgkmcnt(0)
    v_readfirstlane_b32 s78, v13
    s_nop 0
    s_cmp_lg_u32 s78, 31
    s_cbranch_scc1 L_end
    buffer_load_dwordx4 v[72:75], v31, s[56:59], s95 offen sc1
    buffer_load_dwordx4 v[108:111], v26, s[56:59], s94 offen offset:0 sc1
    buffer_load_dwordx4 v[112:115], v26, s[56:59], s94 offen offset:1024 sc1
    buffer_load_dwordx4 v[116:119], v26, s[56:59], s94 offen offset:2048 sc1
    buffer_load_dwordx4 v[120:123], v26, s[56:59], s94 offen offset:3072 sc1
    s_add_u32 s94, s94, 4096
    buffer_load_dwordx4 v[124:127], v26, s[56:59], s94 offen offset:0 sc1
    buffer_load_dwordx4 v[128:131], v26, s[56:59], s94 offen offset:1024 sc1
    buffer_load_dwordx4 v[132:135], v26, s[56:59], s94 offen offset:2048 sc1
    buffer_load_dwordx4 v[136:139], v26, s[56:59], s94 offen offset:3072 sc1
    s_add_u32 s94, s94, 4096
    buffer_load_dwordx4 v[140:143], v26, s[56:59], s94 offen offset:0 sc1
    buffer_load_dwordx4 v[144:147], v26, s[56:59], s94 offen offset:1024 sc1
    s_waitcnt vmcnt(10)
    v_max_f32_dpp v76, v72, v72 quad_perm:[1,0,3,2] row_mask:0xf bank_mask:0xf
    v_max_f32_dpp v77, v73, v73 quad_perm:[1,0,3,2] row_mask:0xf bank_mask:0xf
    s_nop 0
    v_max_f32_dpp v76, v76, v76 quad_perm:[2,3,0,1] row_mask:0xf bank_mask:0xf
    v_max_f32_dpp v77, v77, v77 quad_perm:[2,3,0,1] row_mask:0xf bank_mask:0xf
    s_nop 0
    v_max_f32_dpp v76, v76, v76 row_ror:4 row_mask:0xf bank_mask:0xf
    v_max_f32_dpp v77, v77, v77 row_ror:4 row_mask:0xf bank_mask:0xf
    s_nop 0
    v_max_f32_dpp v76, v76, v76 row_ror:8 row_mask:0xf bank_mask:0xf
    v_max_f32_dpp v77, v77, v77 row_ror:8 row_mask:0xf bank_mask:0xf
    s_nop 0
    v_mov_b32 v78, v76
    v_mov_b32 v79, v77
    s_nop 0
    v_permlane16_swap_b32 v76, v78
    v_permlane16_swap_b32 v77, v79
    v_max_f32 v76, v76, v78
    v_max_f32 v77, v77, v79
    v_sub_f32 v72, v72, v76
    v_sub_f32 v73, v73, v77
    v_exp_f32 v72, v72
    v_exp_f32 v73, v73
    s_nop 0
    ds_write_b64 v27, v[72:73] offset:2560
    v_pk_mul_f32 v[74:75], v[74:75], v[72:73]
    ds_read_b128 v[172:175], v28 offset:2560
    ds_read_b128 v[176:179], v28 offset:2592
    ds_read_b128 v[180:183], v28 offset:2624
    ds_read_b128 v[184:187], v28 offset:2656
    ds_read_b128 v[188:191], v28 offset:2688
    ds_read_b128 v[192:195], v28 offset:2720
    ds_read_b128 v[196:199], v28 offset:2752
    ds_read_b128 v[200:203], v28 offset:2784
    buffer_load_dwordx4 v[148:151], v26, s[56:59], s94 offen offset:2048 sc1
    buffer_load_dwordx4 v[152:155], v26, s[56:59], s94 offen offset:3072 sc1
    s_add_u32 s94, s94, 4096
    buffer_load_dwordx4 v[156:159], v26, s[56:59], s94 offen offset:0 sc1
    buffer_load_dwordx4 v[160:163], v26, s[56:59], s94 offen offset:1024 sc1
    buffer_load_dwordx4 v[164:167], v26, s[56:59], s94 offen offset:2048 sc1
    buffer_load_dwordx4 v[168:171], v26, s[56:59], s94 offen offset:3072 sc1
    v_add_f32_dpp v74, v74, v74 quad_perm:[1,0,3,2] row_mask:0xf bank_mask:0xf
    v_add_f32_dpp v75, v75, v75 quad_perm:[1,0,3,2] row_mask:0xf bank_mask:0xf
    s_nop 0
    v_add_f32_dpp v74, v74, v74 quad_perm:[2,3,0,1] row_mask:0xf bank_mask:0xf
    v_add_f32_dpp v75, v75, v75 quad_perm:[2,3,0,1] row_mask:0xf bank_mask:0xf
    s_nop 0
    v_add_f32_dpp v74, v74, v74 row_ror:4 row_mask:0xf bank_mask:0xf
    v_add_f32_dpp v75, v75, v75 row_ror:4 row_mask:0xf bank_mask:0xf
    s_nop 0
    v_add_f32_dpp v74, v74, v74 row_ror:8 row_mask:0xf bank_mask:0xf
    v_add_f32_dpp v75, v75, v75 row_ror:8 row_mask:0xf bank_mask:0xf
    s_nop 0
    v_mov_b32 v78, v74
    v_mov_b32 v79, v75
    s_nop 0
    v_permlane16_swap_b32 v74, v78
    v_permlane16_swap_b32 v75, v79
    v_add_f32 v74, v74, v78
    v_add_f32 v75, v75, v79
    v_rcp_f32 v74, v74
    v_rcp_f32 v75, v75
    s_waitcnt lgkmcnt(0)
    s_waitcnt vmcnt(15)
    v_pk_mul_f32 v[80:81], v[172:173], v[108:109]
    v_pk_mul_f32 v[82:83], v[174:175], v[110:111]
    ds_read_b128 v[172:175], v28 offset:2816
    s_waitcnt vmcnt(14)
    v_pk_mul_f32 v[84:85], v[176:177], v[112:113]
    v_pk_mul_f32 v[86:87], v[178:179], v[114:115]
    ds_read_b128 v[176:179], v28 offset:2848
    s_waitcnt vmcnt(13)
    v_pk_fma_f32 v[80:81], v[180:181], v[116:117], v[80:81]
    v_pk_fma_f32 v[82:83], v[182:183], v[118:119], v[82:83]
    ds_read_b128 v[180:183], v28 offset:2880
    s_waitcnt vmcnt(12)
    v_pk_fma_f32 v[84:85], v[184:185], v[120:121], v[84:85]
    v_pk_fma_f32 v[86:87], v[186:187], v[122:123], v[86:87]
    ds_read_b128 v[184:187], v28 offset:2912
    s_waitcnt vmcnt(11)
    v_pk_fma_f32 v[80:81], v[188:189], v[124:125], v[80:81]
    v_pk_fma_f32 v[82:83], v[190:191], v[126:127], v[82:83]
    ds_read_b128 v[188:191], v28 offset:2944
    s_waitcnt vmcnt(10)
    v_pk_fma_f32 v[84:85], v[192:193], v[128:129], v[84:85]
    v_pk_fma_f32 v[86:87], v[194:195], v[130:131], v[86:87]
    ds_read_b128 v[192:195], v28 offset:2976
    s_waitcnt vmcnt(9)
    v_pk_fma_f32 v[80:81], v[196:197], v[132:133], v[80:81]
    v_pk_fma_f32 v[82:83], v[198:199], v[134:135], v[82:83]
    ds_read_b128 v[196:199], v28 offset:3008
    s_waitcnt vmcnt(8)
    v_pk_fma_f32 v[84:85], v[200:201], v[136:137], v[84:85]
    v_pk_fma_f32 v[86:87], v[202:203], v[138:139], v[86:87]
    ds_read_b128 v[200:203], v28 offset:3040
    s_waitcnt vmcnt(7)
    s_waitcnt lgkmcnt(0)
    v_pk_fma_f32 v[80:81], v[172:173], v[140:141], v[80:81]
    v_pk_fma_f32 v[82:83], v[174:175], v[142:143], v[82:83]
    s_waitcnt vmcnt(6)
    v_pk_fma_f32 v[84:85], v[176:177], v[144:145], v[84:85]
    v_pk_fma_f32 v[86:87], v[178:179], v[146:147], v[86:87]
    s_waitcnt vmcnt(5)
    v_pk_fma_f32 v[80:81], v[180:181], v[148:149], v[80:81]
    v_pk_fma_f32 v[82:83], v[182:183], v[150:151], v[82:83]
    s_waitcnt vmcnt(4)
    v_pk_fma_f32 v[84:85], v[184:185], v[152:153], v[84:85]
    v_pk_fma_f32 v[86:87], v[186:187], v[154:155], v[86:87]
    s_waitcnt vmcnt(3)
    v_pk_fma_f32 v[80:81], v[188:189], v[156:157], v[80:81]
    v_pk_fma_f32 v[82:83], v[190:191], v[158:159], v[82:83]
    s_waitcnt vmcnt(2)
    v_pk_fma_f32 v[84:85], v[192:193], v[160:161], v[84:85]
    v_pk_fma_f32 v[86:87], v[194:195], v[162:163], v[86:87]
    s_waitcnt vmcnt(1)
    v_pk_fma_f32 v[80:81], v[196:197], v[164:165], v[80:81]
    v_pk_fma_f32 v[82:83], v[198:199], v[166:167], v[82:83]
    s_waitcnt vmcnt(0)
    v_pk_fma_f32 v[84:85], v[200:201], v[168:169], v[84:85]
    v_pk_fma_f32 v[86:87], v[202:203], v[170:171], v[86:87]
    v_pk_add_f32 v[80:81], v[80:81], v[84:85]
    v_pk_add_f32 v[82:83], v[82:83], v[86:87]
    s_nop 1
    v_permlane32_swap_b32 v80, v82
    v_permlane32_swap_b32 v81, v83
    v_pk_add_f32 v[80:81], v[80:81], v[82:83]
    v_pk_mul_f32 v[80:81], v[80:81], v[74:75]
    v_cvt_pk_bf16_f32 v80, v80, v81
    buffer_store_short v80, v29, s[52:55], s82 offen
    buffer_store_short_d16_hi v80, v29, s[52:55], s82 offen offset:256
L_end:
    s_endpgm
.section .rodata,"a"
.p2align 6
.amdhsa_kernel standalone__kv_cache_quant_int4_int2_kv_with_per_channel_or_per_token_scales__decode_kernel
  .amdhsa_next_free_vgpr 208
  .amdhsa_next_free_sgpr 102
  .amdhsa_accum_offset 208
  .amdhsa_group_segment_fixed_size 0
  .amdhsa_kernarg_size 80
  .amdhsa_user_sgpr_count 2
  .amdhsa_user_sgpr_kernarg_segment_ptr 1
  .amdhsa_system_sgpr_workgroup_id_x 1
  .amdhsa_float_denorm_mode_32 3
.end_amdhsa_kernel
```
